```python
import torch

def _softmax(x, axis=-1):
    return torch.softmax(x, dim=axis)
def _gelu(x):
    return torch.nn.functional.gelu(x, approximate="tanh")
def _silu(x):
    return torch.nn.functional.silu(x)
def _sigmoid(x):
    return torch.sigmoid(x)
def _layernorm(x, axis=-1, eps=1e-5):
    m = x.mean(dim=axis, keepdim=True)
    v = x.var(dim=axis, keepdim=True, unbiased=False)
    return (x - m) / torch.sqrt(v + eps)
def _scatter_add(tgt, idx, src, axis=0):
    return tgt.clone().index_add_(axis, idx, src)
def _segment_sum(src, seg, n):
    out = torch.zeros((n,) + src.shape[1:], dtype=src.dtype)
    return out.index_add_(0, seg, src)
def _pad(x, pw):
    flat = tuple(v for pair in reversed(pw) for v in pair)
    return torch.nn.functional.pad(x, flat)

kernel_name = 'standalone__w8a8_smoothquant_per_tensor_per_channel_int8_activations_weights__sampling'

def setup_inputs():

    _w = (lambda a: (lambda t: t.to(torch.bfloat16) if t.is_floating_point() else t)(torch.as_tensor(a)))
    B, S, D, F = 32, 16, 1024, 3584
    x = abs((lambda *s: torch.randn(*s, dtype=torch.bfloat16) * 0.05)(B, S, D))
    w = (lambda *s: torch.randn(*s, dtype=torch.bfloat16) * 0.05)(D, F)
    x_min, x_max = float(x.min()), float(x.max())
    sx = (x_max - x_min) / 255.0 + 1e-6
    zx = int(torch.as_tensor(-128.0 - x_min / sx).round())
    qx = torch.clamp(torch.as_tensor(x / sx).round() + zx, -128, 127).to(torch.int32)
    sw = (torch.abs(w).amax(dim=0) / 127.0 + 1e-6).to(float)
    qw = torch.clamp(torch.as_tensor(w / sw[None, :]).round(), -127, 127).to(torch.int32)
    return {
        "qx": _w(qx),
        "qw": _w(qw),
        "scale_x": _w(torch.tensor(sx, dtype=float)),
        "zero_x": _w(torch.tensor(zx, dtype=torch.int32)),
        "scale_w": _w(sw),
        "bias": _w((lambda *s: torch.randn(*s, dtype=torch.bfloat16) * 0.05)(F)),
    }

def reference(qx, qw, scale_x, zero_x, scale_w, bias):
    dt = scale_w.dtype
    acc = torch.einsum("bsd,df->bsf", (lambda x, dt: x.to(dt))(qx, dt), (lambda x, dt: x.to(dt))(qw, dt))
    w_colsum = torch.sum((lambda x, dt: x.to(dt))(qw, dt), axis=0)
    acc = acc - (lambda x, dt: x.to(dt))(zero_x, dt) * w_colsum[None, None, :]
    return acc * scale_x * scale_w[None, None, :] + bias[None, None, :]
```

```asm
; @launch grid=(256,1,1) block=(256,1,1) lds=33024
.amdgcn_target "amdgcn-amd-amdhsa--gfx950"
.text
.globl standalone__w8a8_smoothquant_per_tensor_per_channel_int8_activations_weights__sampling_kernel
.p2align 8
.type standalone__w8a8_smoothquant_per_tensor_per_channel_int8_activations_weights__sampling_kernel,@function
standalone__w8a8_smoothquant_per_tensor_per_channel_int8_activations_weights__sampling_kernel:
    s_load_dwordx2 s[28:29], s[0:1], 8
    s_load_dwordx16 s[4:19], s[0:1], 0
    s_load_dwordx2 s[20:21], s[0:1], 64

    s_sub_u32 s22, s2, 32

    s_cbranch_scc0 L_g1
    s_getpc_b64 s[74:75]
L_pc:
    v_lshlrev_b32 v1, 7, v0
    v_min_u32 v1, L_codeend-L_pc-4, v1
    global_load_dword v1, v1, s[74:75]

    s_branch L_prod
L_g1:
    s_cmp_ge_u32 s22, 224
    s_cbranch_scc1 L_end
    s_bfe_u32 s23, s22, 0x10003
    s_lshr_b32 s22, s22, 4
    s_and_b32 s63, s2, 7
    s_mul_i32 s63, s63, 14
    s_add_u32 s63, s63, s22
    s_and_b32 s61, s63, 7
    s_lshl_b32 s63, s63, 7
    v_bfe_u32 v24, v0, 4, 3
    v_and_b32 v26, 8, v0
    v_lshl_add_u32 v4, v26, 1, v24
    v_lshrrev_b32 v25, 7, v0
    v_lshl_add_u32 v4, v25, 5, v4
    v_mul_u32_u24 v4, 57344, v4
    v_and_b32 v16, 7, v0
    v_lshl_add_u32 v4, v16, 4, v4
    s_cmp_eq_u32 s61, 3
    s_cselect_b32 s61, s23, 0
    s_lshr_b32 s57, s22, 8
    s_lshl1_add_u32 s61, s61, s57
    s_and_b32 s61, s61, 3
    s_mov_b32 s30, 14680064
    s_mov_b32 s31, 0x00020000
    s_mul_i32 s52, s61, 3670016
    s_add_u32 s52, s52, s63
    s_add_u32 s53, s52, 14336
    s_add_u32 s54, s52, 28672
    s_add_u32 s55, s52, 43008
    s_waitcnt lgkmcnt(0)

    buffer_load_dwordx4 v[128:131], v4, s[28:31], s52 offen
    buffer_load_dwordx4 v[132:135], v4, s[28:31], s53 offen
    buffer_load_dwordx4 v[136:139], v4, s[28:31], s54 offen
    buffer_load_dwordx4 v[140:143], v4, s[28:31], s55 offen
    s_mov_b32 s57, s61
    s_mov_b32 s78, s63
    v_readfirstlane_b32 s3, v0
    v_and_b32 v27, 63, v0
    s_add_u32 s52, s52, 458752
    s_add_u32 s53, s53, 458752
    s_add_u32 s54, s54, 458752
    s_add_u32 s55, s55, 458752
    s_lshr_b32 s3, s3, 6
    s_lshr_b32 s72, s2, 5
    s_sub_u32 s72, s72, 1
    s_lshl2_add_u32 s72, s72, s3
    s_mul_i32 s72, s72, 19
    v_add_u32 v2, s72, v27
    v_min_u32 v2, 511, v2
    v_lshlrev_b32 v2, 7, v2

    s_and_b32 s72, s2, 25
    s_bfe_u32 s73, s2, 0x10001
    s_lshl2_add_u32 s72, s73, s72
    s_bfe_u32 s73, s2, 0x10002
    s_lshl1_add_u32 s72, s73, s72

    s_lshl_b32 s72, s72, 16
    s_mov_b32 s24, s4
    s_mov_b32 s25, s5
    s_mov_b32 s26, 2097152
    s_mov_b32 s27, 0x00020000
    s_mov_b64 exec, 524287
    buffer_load_dword v2, v2, s[24:27], s72 offen
    s_mov_b64 exec, -1

    buffer_load_dwordx4 v[144:147], v4, s[28:31], s52 offen
    buffer_load_dwordx4 v[148:151], v4, s[28:31], s53 offen
    buffer_load_dwordx4 v[152:155], v4, s[28:31], s54 offen
    buffer_load_dwordx4 v[156:159], v4, s[28:31], s55 offen
    s_add_u32 s57, s57, 1
    s_and_b32 s57, s57, 3
    s_mul_i32 s52, s57, 3670016
    s_add_u32 s52, s52, s78
    s_add_u32 s53, s52, 14336
    s_add_u32 s54, s52, 28672
    s_add_u32 s55, s52, 43008
    s_bfe_u32 s74, s78, 0x30007
    s_lshl1_add_u32 s74, s74, s23
    s_lshl2_add_u32 s74, s74, s3
    s_lshl_b32 s74, s74, 3
    s_and_b32 s75, s74, 256
    s_add_u32 s74, s74, s75
    s_add_u32 s74, s74, 256
    s_mul_i32 s74, s74, 14336
    s_andn2_b32 s75, s78, 0x380
    s_add_u32 s74, s74, s75
    v_mul_u32_u24 v3, 14336, v27
    s_mov_b64 exec, 255
    buffer_load_dword v3, v3, s[28:31], s74 offen offset:384
    s_mov_b64 exec, -1

    buffer_load_dwordx4 v[160:163], v4, s[28:31], s52 offen
    buffer_load_dwordx4 v[164:167], v4, s[28:31], s53 offen
    buffer_load_dwordx4 v[168:171], v4, s[28:31], s54 offen
    buffer_load_dwordx4 v[172:175], v4, s[28:31], s55 offen
    s_add_u32 s52, s52, 458752
    s_add_u32 s53, s53, 458752
    s_add_u32 s54, s54, 458752
    s_add_u32 s55, s55, 458752
    s_branch L_gemm
L_prod:
    s_memrealtime s[58:59]
    v_readfirstlane_b32 s3, v0
    v_bfe_u32 v24, v0, 3, 3
    v_and_b32 v25, 7, v0

    s_and_b32 s22, s2, 25
    s_bfe_u32 s23, s2, 0x10001
    s_lshl2_add_u32 s22, s23, s22
    s_bfe_u32 s23, s2, 0x10002
    s_lshl1_add_u32 s22, s23, s22

    s_lshr_b32 s3, s3, 6
    s_lshl_b32 s52, s22, 16
    s_lshl_b32 s53, s3, 10
    s_add_u32 s52, s52, s53
    s_add_u32 s53, s52, 0x8000
    v_lshlrev_b32 v4, 12, v24
    v_lshl_add_u32 v4, v25, 4, v4
    s_mov_b32 s26, 2097152
    s_mov_b32 s27, 0x00020000
    s_mov_b32 s46, 256
    s_mov_b32 s47, 0x00020000
    v_mov_b32 v18, 0
    s_cmp_lg_u32 s52, 3072
    s_waitcnt lgkmcnt(0)
    s_mov_b32 s24, s4
    s_mov_b32 s25, s5
    s_mov_b32 s44, s18
    s_mov_b32 s45, s19
    s_cbranch_scc1 L_nononce
    s_or_b32 s60, s58, 1
    s_or_b32 s61, s59, 0x80000000
    v_mov_b32 v28, s60
    v_mov_b32 v29, s61
    v_mov_b32 v30, s60
    v_mov_b32 v31, s61
    v_lshlrev_b32 v26, 4, v25
    s_mov_b64 exec, 0xff
    buffer_store_dwordx4 v[28:31], v26, s[44:47], 0 offen sc1
    s_mov_b64 exec, -1

L_nononce:
    buffer_load_dwordx4 v[128:131], v4, s[24:27], s52 offen offset:0
    buffer_load_dwordx4 v[132:135], v4, s[24:27], s52 offen offset:128
    buffer_load_dwordx4 v[136:139], v4, s[24:27], s52 offen offset:256
    buffer_load_dwordx4 v[140:143], v4, s[24:27], s52 offen offset:384
    buffer_load_dwordx4 v[144:147], v4, s[24:27], s53 offen offset:0
    buffer_load_dwordx4 v[148:151], v4, s[24:27], s53 offen offset:128
    buffer_load_dwordx4 v[152:155], v4, s[24:27], s53 offen offset:256
    buffer_load_dwordx4 v[156:159], v4, s[24:27], s53 offen offset:384
    buffer_load_dwordx4 v[160:163], v4, s[24:27], s52 offen offset:512
    buffer_load_dwordx4 v[164:167], v4, s[24:27], s52 offen offset:640
    buffer_load_dwordx4 v[168:171], v4, s[24:27], s52 offen offset:768
    buffer_load_dwordx4 v[172:175], v4, s[24:27], s52 offen offset:896
    buffer_load_dwordx4 v[176:179], v4, s[24:27], s53 offen offset:512
    buffer_load_dwordx4 v[180:183], v4, s[24:27], s53 offen offset:640
    buffer_load_dwordx4 v[184:187], v4, s[24:27], s53 offen offset:768
    buffer_load_dwordx4 v[188:191], v4, s[24:27], s53 offen offset:896
    s_mov_b32 s56, 0x0c0c0400
    s_lshl2_add_u32 s63, s22, s3
    s_mov_b32 s48, s20
    s_mov_b32 s49, s21
    s_mov_b32 s50, 557184
    s_mov_b32 s51, 0x00020000
    s_lshl_b32 s54, s63, 12
    v_lshlrev_b32 v11, 8, v25
    v_lshl_add_u32 v11, v24, 4, v11

    v_lshlrev_b32 v17, 12, v24
    v_lshl_add_u32 v17, v25, 4, v17
    s_lshl_b32 s55, s22, 7
    s_add_u32 s55, s55, 524288
    s_mov_b32 s57, 0

    s_mov_b32 s16, 557056
    buffer_load_dword v2, v18, s[48:51], s16 offen
    buffer_load_dword v3, v18, s[44:47], 0 offen offset:192
    s_waitcnt vmcnt(14)
    v_perm_b32 v24, v129, v128, s56
    v_perm_b32 v25, v131, v130, s56
    v_lshl_or_b32 v112, v25, 16, v24
    v_perm_b32 v24, v133, v132, s56
    v_perm_b32 v25, v135, v134, s56
    v_lshl_or_b32 v113, v25, 16, v24
    v_perm_b32 v24, v137, v136, s56
    v_perm_b32 v25, v139, v138, s56
    v_lshl_or_b32 v114, v25, 16, v24
    v_perm_b32 v24, v141, v140, s56
    v_perm_b32 v25, v143, v142, s56
    v_lshl_or_b32 v115, v25, 16, v24
    buffer_store_dwordx4 v[112:115], v11, s[48:51], s54 offen offset:0 sc1
    s_waitcnt vmcnt(11)
    v_perm_b32 v24, v145, v144, s56
    v_perm_b32 v25, v147, v146, s56
    v_lshl_or_b32 v116, v25, 16, v24
    v_perm_b32 v24, v149, v148, s56
    v_perm_b32 v25, v151, v150, s56
    v_lshl_or_b32 v117, v25, 16, v24
    v_perm_b32 v24, v153, v152, s56
    v_perm_b32 v25, v155, v154, s56
    v_lshl_or_b32 v118, v25, 16, v24
    v_perm_b32 v24, v157, v156, s56
    v_perm_b32 v25, v159, v158, s56
    v_lshl_or_b32 v119, v25, 16, v24
    buffer_store_dwordx4 v[116:119], v11, s[48:51], s54 offen offset:128 sc1
    s_waitcnt vmcnt(8)
    v_perm_b32 v24, v161, v160, s56
    v_perm_b32 v25, v163, v162, s56
    v_lshl_or_b32 v120, v25, 16, v24
    v_perm_b32 v24, v165, v164, s56
    v_perm_b32 v25, v167, v166, s56
    v_lshl_or_b32 v121, v25, 16, v24
    v_perm_b32 v24, v169, v168, s56
    v_perm_b32 v25, v171, v170, s56
    v_lshl_or_b32 v122, v25, 16, v24
    v_perm_b32 v24, v173, v172, s56
    v_perm_b32 v25, v175, v174, s56
    v_lshl_or_b32 v123, v25, 16, v24
    buffer_store_dwordx4 v[120:123], v11, s[48:51], s54 offen offset:2048 sc1
    s_waitcnt vmcnt(5)
    v_perm_b32 v24, v177, v176, s56
    v_perm_b32 v25, v179, v178, s56
    v_lshl_or_b32 v124, v25, 16, v24
    v_perm_b32 v24, v181, v180, s56
    v_perm_b32 v25, v183, v182, s56
    v_lshl_or_b32 v125, v25, 16, v24
    v_perm_b32 v24, v185, v184, s56
    v_perm_b32 v25, v187, v186, s56
    v_lshl_or_b32 v126, v25, 16, v24
    v_perm_b32 v24, v189, v188, s56
    v_perm_b32 v25, v191, v190, s56
    v_lshl_or_b32 v127, v25, 16, v24
    buffer_store_dwordx4 v[124:127], v11, s[48:51], s54 offen offset:2176 sc1
L_nonce:
    buffer_load_dwordx4 v[28:31], v18, s[44:47], 0 offen sc1
    s_add_u32 s57, s57, 1
    s_cmp_ge_u32 s57, 0x40000
    s_waitcnt vmcnt(0)
    s_cbranch_scc1 L_ndone
    v_min_u32 v24, v28, v29
    v_cmp_eq_u32 vcc, 0, v24
    s_cbranch_vccnz L_nonce

L_ndone:
    s_barrier
    s_cmp_lg_u32 s3, 0
    s_cbranch_scc1 L_pend
    s_mov_b32 exec_lo, 0xffffffff
    s_mov_b32 exec_hi, 0xffffffff
    buffer_store_dwordx4 v[28:31], v17, s[48:51], s55 offen sc1

L_pend:
L_end:
    s_endpgm
L_gemm:
    v_mov_b32 v18, 0
    v_lshlrev_b32 v19, 2, v27
    ds_write_b32 v19, v18 offset:32768
    s_load_dword s58, s[8:9], 0
    s_load_dword s60, s[10:11], 0
    v_xor_b32 v24, v24, v16
    v_lshl_add_u32 v5, v24, 4, v26
    v_lshl_add_u32 v5, v25, 12, v5
    v_and_b32 v24, 1, v0
    v_lshl_add_u32 v5, v24, 11, v5
    v_bfe_u32 v24, v0, 1, 2
    v_lshl_add_u32 v5, v24, 9, v5
    v_xor_b32 v6, 16, v5
    v_lshlrev_b32 v19, 4, v16
    s_mov_b32 s56, 0x0c0c0400
    s_mov_b32 s36, s12
    s_mov_b32 s37, s13
    s_mov_b32 s38, 7168
    s_mov_b32 s39, 0x00020000
    s_mov_b32 s40, s14
    s_mov_b32 s41, s15
    s_mov_b32 s42, 7168
    s_mov_b32 s43, 0x00020000
    v_and_b32 v16, 0x30, v0
    v_lshlrev_b32 v20, 1, v16
    s_lshr_b32 s63, s78, 1
    v_add_u32 v16, s63, v16
    buffer_load_dwordx4 v[104:107], v16, s[36:39], 0 offen
    buffer_load_dwordx4 v[108:111], v16, s[40:43], 0 offen

    s_mov_b32 s32, s16
    s_mov_b32 s33, s17
    s_mov_b32 s34, 3670016
    s_mov_b32 s35, 0x00020000
    s_mov_b32 s48, s20
    s_mov_b32 s49, s21
    s_mov_b32 s50, 557184
    s_mov_b32 s51, 0x00020000
    s_mov_b32 s44, s18
    s_mov_b32 s45, s19
    s_mov_b32 s46, 256
    s_mov_b32 s47, 0x00020000
    v_lshrrev_b32 v26, 4, v27
    v_and_b32 v25, 15, v0
    v_bfe_u32 v24, v0, 1, 3
    v_xor_b32 v24, v24, v26
    v_lshlrev_b32 v24, 4, v24
    v_lshl_add_u32 v7, v25, 7, v24
    v_xor_b32 v8, 16, v7
    v_add_u32 v8, 2048, v8
    v_xor_b32 v9, 64, v7
    v_xor_b32 v10, 64, v8
    s_lshl2_add_u32 s63, s23, s3
    s_lshl_b32 s62, s63, 9
    s_add_u32 s62, s62, 524288
    s_lshl_b32 s23, s63, 6

    v_add_u32 v24, s23, v25
    v_mul_u32_u24 v15, 7168, v24
    v_add_u32 v15, v15, v16

    s_bfe_u32 s22, s22, 0
    s_lshl_b32 s23, s63, 16
    s_lshl_b32 s63, s22, 14
    s_add_u32 s23, s23, s63
    v_lshl_add_u32 v11, v27, 4, s23
    v_xor_b32 v12, 0x4000, v11
    v_add_u32 v13, 0x8000, v11
    v_add_u32 v14, 0x8000, v12
    s_mul_i32 s4, s22, 114688
    s_sub_u32 s5, 114688, s4
    s_add_u32 s6, s4, 229376
    s_add_u32 s7, s5, 229376
    v_and_b32 v17, 1, v0
    v_lshlrev_b32 v17, 7, v17

    s_lshl_b32 s12, s61, 12
    s_add_u32 s13, s12, 4096
    s_and_b32 s13, s13, 0x3fff
    s_add_u32 s14, s13, 4096
    s_and_b32 s14, s14, 0x3fff
    s_add_u32 s15, s14, 4096
    s_and_b32 s15, s15, 0x3fff
    v_mov_b32 v44, 0
    v_mov_b32 v45, 0
    v_mov_b32 v46, 0
    v_mov_b32 v47, 0
    s_mov_b32 s16, 557056
    buffer_load_dword v1, v18, s[48:51], s16 offen
    s_load_dword s96, s[20:21], 557056
    s_load_dword s97, s[18:19], 192
    s_waitcnt vmcnt(13)
    buffer_load_dwordx4 v[176:179], v4, s[28:31], s52 offen
    buffer_load_dwordx4 v[180:183], v4, s[28:31], s53 offen
    buffer_load_dwordx4 v[184:187], v4, s[28:31], s54 offen
    buffer_load_dwordx4 v[188:191], v4, s[28:31], s55 offen
    s_add_u32 s57, s57, 1
    s_and_b32 s57, s57, 3
    s_mul_i32 s52, s57, 3670016
    s_add_u32 s52, s52, s78
    s_add_u32 s53, s52, 14336
    s_add_u32 s54, s52, 28672
    s_add_u32 s55, s52, 43008
    v_perm_b32 v24, v132, v128, s56
    v_perm_b32 v25, v140, v136, s56
    v_lshl_or_b32 v36, v25, 16, v24
    v_perm_b32 v24, v133, v129, s56
    v_perm_b32 v25, v141, v137, s56
    v_lshl_or_b32 v38, v25, 16, v24
    v_perm_b32 v24, v134, v130, s56
    v_perm_b32 v25, v142, v138, s56
    v_lshl_or_b32 v40, v25, 16, v24
    v_perm_b32 v24, v135, v131, s56
    v_perm_b32 v25, v143, v139, s56
    v_lshl_or_b32 v42, v25, 16, v24
    v_dot4c_i32_i8 v44, 0x01010101, v36
    v_dot4c_i32_i8 v45, 0x01010101, v38
    v_dot4c_i32_i8 v46, 0x01010101, v40
    v_dot4c_i32_i8 v47, 0x01010101, v42
    s_waitcnt vmcnt(12)
    buffer_load_dwordx4 v[128:131], v4, s[28:31], s52 offen
    buffer_load_dwordx4 v[132:135], v4, s[28:31], s53 offen
    buffer_load_dwordx4 v[136:139], v4, s[28:31], s54 offen
    buffer_load_dwordx4 v[140:143], v4, s[28:31], s55 offen
    s_add_u32 s52, s52, 458752
    s_add_u32 s53, s53, 458752
    s_add_u32 s54, s54, 458752
    s_add_u32 s55, s55, 458752
    v_perm_b32 v24, v148, v144, s56
    v_perm_b32 v25, v156, v152, s56
    v_lshl_or_b32 v37, v25, 16, v24
    v_perm_b32 v24, v149, v145, s56
    v_perm_b32 v25, v157, v153, s56
    v_lshl_or_b32 v39, v25, 16, v24
    v_perm_b32 v24, v150, v146, s56
    v_perm_b32 v25, v158, v154, s56
    v_lshl_or_b32 v41, v25, 16, v24
    v_perm_b32 v24, v151, v147, s56
    v_perm_b32 v25, v159, v155, s56
    v_lshl_or_b32 v43, v25, 16, v24
    ds_write_b64 v5, v[36:37] offset:0
    ds_write_b64 v5, v[38:39] offset:128
    ds_write_b64 v6, v[40:41] offset:256
    ds_write_b64 v6, v[42:43] offset:384
    v_dot4c_i32_i8 v44, 0x01010101, v37
    v_dot4c_i32_i8 v45, 0x01010101, v39
    v_dot4c_i32_i8 v46, 0x01010101, v41
    v_dot4c_i32_i8 v47, 0x01010101, v43
    s_waitcnt lgkmcnt(0)
    s_barrier
    s_lshl_b32 s58, s58, 16
    s_mov_b32 s59, s58
    v_cvt_f32_i32 v21, s60
    v_cvt_pk_bf16_f32 v21, 0, -v21

    ds_read_b128 a[0:3], v7 offset:0
    ds_read_b128 a[4:7], v8 offset:0
    ds_read_b128 a[8:11], v9 offset:0
    ds_read_b128 a[12:15], v10 offset:0
    ds_read_b128 a[16:19], v7 offset:4096
    ds_read_b128 a[20:23], v8 offset:4096
    ds_read_b128 a[24:27], v9 offset:4096
    ds_read_b128 a[28:31], v10 offset:4096
    s_waitcnt vmcnt(11)
    buffer_load_dwordx4 v[144:147], v4, s[28:31], s52 offen
    buffer_load_dwordx4 v[148:151], v4, s[28:31], s53 offen
    buffer_load_dwordx4 v[152:155], v4, s[28:31], s54 offen
    buffer_load_dwordx4 v[156:159], v4, s[28:31], s55 offen
    s_add_u32 s57, s57, 1
    s_and_b32 s57, s57, 3
    s_mul_i32 s52, s57, 3670016
    s_add_u32 s52, s52, s78
    s_add_u32 s53, s52, 14336
    s_add_u32 s54, s52, 28672
    s_add_u32 s55, s52, 43008
    v_perm_b32 v24, v164, v160, s56
    v_perm_b32 v25, v172, v168, s56
    v_lshl_or_b32 v36, v25, 16, v24
    v_perm_b32 v24, v165, v161, s56
    v_perm_b32 v25, v173, v169, s56
    v_lshl_or_b32 v38, v25, 16, v24
    v_perm_b32 v24, v166, v162, s56
    v_perm_b32 v25, v174, v170, s56
    v_lshl_or_b32 v40, v25, 16, v24
    v_perm_b32 v24, v167, v163, s56
    v_perm_b32 v25, v175, v171, s56
    v_lshl_or_b32 v42, v25, 16, v24
    v_dot4c_i32_i8 v44, 0x01010101, v36
    v_dot4c_i32_i8 v45, 0x01010101, v38
    v_dot4c_i32_i8 v46, 0x01010101, v40
    v_dot4c_i32_i8 v47, 0x01010101, v42
    s_waitcnt vmcnt(8)
    buffer_load_dwordx4 v[160:163], v4, s[28:31], s52 offen
    buffer_load_dwordx4 v[164:167], v4, s[28:31], s53 offen
    buffer_load_dwordx4 v[168:171], v4, s[28:31], s54 offen
    buffer_load_dwordx4 v[172:175], v4, s[28:31], s55 offen
    s_add_u32 s52, s52, 458752
    s_add_u32 s53, s53, 458752
    s_add_u32 s54, s54, 458752
    s_add_u32 s55, s55, 458752
    v_perm_b32 v24, v180, v176, s56
    v_perm_b32 v25, v188, v184, s56
    v_lshl_or_b32 v37, v25, 16, v24
    v_perm_b32 v24, v181, v177, s56
    v_perm_b32 v25, v189, v185, s56
    v_lshl_or_b32 v39, v25, 16, v24
    v_perm_b32 v24, v182, v178, s56
    v_perm_b32 v25, v190, v186, s56
    v_lshl_or_b32 v41, v25, 16, v24
    v_perm_b32 v24, v183, v179, s56
    v_perm_b32 v25, v191, v187, s56
    v_lshl_or_b32 v43, v25, 16, v24
    ds_write_b64 v5, v[36:37] offset:8192
    ds_write_b64 v5, v[38:39] offset:8320
    ds_write_b64 v6, v[40:41] offset:8448
    ds_write_b64 v6, v[42:43] offset:8576
    v_dot4c_i32_i8 v44, 0x01010101, v37
    v_dot4c_i32_i8 v45, 0x01010101, v39
    v_dot4c_i32_i8 v46, 0x01010101, v41
    v_dot4c_i32_i8 v47, 0x01010101, v43
    v_lshlrev_b32 v80, 16, v104
    v_and_b32 v81, 0xffff0000, v104
    v_lshlrev_b32 v88, 16, v108
    v_and_b32 v89, 0xffff0000, v108
    v_lshlrev_b32 v82, 16, v105
    v_and_b32 v83, 0xffff0000, v105
    v_lshlrev_b32 v90, 16, v109
    v_and_b32 v91, 0xffff0000, v109
    v_lshlrev_b32 v84, 16, v106
    v_and_b32 v85, 0xffff0000, v106
    v_lshlrev_b32 v92, 16, v110
    v_and_b32 v93, 0xffff0000, v110
    v_lshlrev_b32 v86, 16, v107
    v_and_b32 v87, 0xffff0000, v107
    v_lshlrev_b32 v94, 16, v111
    v_and_b32 v95, 0xffff0000, v111
    s_waitcnt lgkmcnt(0)
    s_barrier
    ds_read_b128 a[32:35], v7 offset:8192
    ds_read_b128 a[36:39], v8 offset:8192
    ds_read_b128 a[40:43], v9 offset:8192
    ds_read_b128 a[44:47], v10 offset:8192
    ds_read_b128 a[48:51], v7 offset:12288
    ds_read_b128 a[52:55], v8 offset:12288
    ds_read_b128 a[56:59], v9 offset:12288
    ds_read_b128 a[60:63], v10 offset:12288
    s_waitcnt vmcnt(8)
    buffer_load_dwordx4 v[176:179], v4, s[28:31], s52 offen
    buffer_load_dwordx4 v[180:183], v4, s[28:31], s53 offen
    buffer_load_dwordx4 v[184:187], v4, s[28:31], s54 offen
    buffer_load_dwordx4 v[188:191], v4, s[28:31], s55 offen
    v_perm_b32 v24, v132, v128, s56
    v_perm_b32 v25, v140, v136, s56
    v_lshl_or_b32 v36, v25, 16, v24
    v_perm_b32 v24, v133, v129, s56
    v_perm_b32 v25, v141, v137, s56
    v_lshl_or_b32 v38, v25, 16, v24
    v_perm_b32 v24, v134, v130, s56
    v_perm_b32 v25, v142, v138, s56
    v_lshl_or_b32 v40, v25, 16, v24
    v_perm_b32 v24, v135, v131, s56
    v_perm_b32 v25, v143, v139, s56
    v_lshl_or_b32 v42, v25, 16, v24
    v_dot4c_i32_i8 v44, 0x01010101, v36
    v_dot4c_i32_i8 v45, 0x01010101, v38
    v_dot4c_i32_i8 v46, 0x01010101, v40
    v_dot4c_i32_i8 v47, 0x01010101, v42
    s_waitcnt vmcnt(8)
    s_add_u32 s79, s62, 0
    s_mov_b32 s16, 0
    s_lshl_b32 s17, s16, 6
    s_and_b32 s17, s17, 0x40
    s_load_dwordx2 s[96:97], s[18:19], s17
    s_load_dwordx2 s[80:81], s[20:21], s79 offset:0
    s_load_dwordx2 s[82:83], s[20:21], s79 offset:128
    s_add_u32 s79, s79, 4096
    s_add_u32 s16, s16, 1
    v_perm_b32 v24, v148, v144, s56
    v_perm_b32 v25, v156, v152, s56
    v_lshl_or_b32 v37, v25, 16, v24
    v_perm_b32 v24, v149, v145, s56
    v_perm_b32 v25, v157, v153, s56
    v_lshl_or_b32 v39, v25, 16, v24
    v_perm_b32 v24, v150, v146, s56
    v_perm_b32 v25, v158, v154, s56
    v_lshl_or_b32 v41, v25, 16, v24
    v_perm_b32 v24, v151, v147, s56
    v_perm_b32 v25, v159, v155, s56
    v_lshl_or_b32 v43, v25, 16, v24
    ds_write_b64 v5, v[36:37] offset:16384
    ds_write_b64 v5, v[38:39] offset:16512
    ds_write_b64 v6, v[40:41] offset:16640
    ds_write_b64 v6, v[42:43] offset:16768
    v_dot4c_i32_i8 v44, 0x01010101, v37
    v_dot4c_i32_i8 v45, 0x01010101, v39
    v_dot4c_i32_i8 v46, 0x01010101, v41
    v_dot4c_i32_i8 v47, 0x01010101, v43
    s_waitcnt lgkmcnt(0)
    s_cmp_eq_u32 s96, 0
    s_cbranch_scc1 L_fail5
    s_cmp_lg_u64 s[80:81], s[96:97]
    s_cbranch_scc1 L_fail5
    s_cmp_lg_u64 s[82:83], s[96:97]
    s_cbranch_scc1 L_fail5
    buffer_load_dwordx4 a[128:131], v11, s[48:51], s12 offen offset:0 sc1
    buffer_load_dwordx4 a[132:135], v11, s[48:51], s12 offen offset:1024 sc1
    buffer_load_dwordx4 a[136:139], v11, s[48:51], s12 offen offset:2048 sc1
    buffer_load_dwordx4 a[140:143], v11, s[48:51], s12 offen offset:3072 sc1
    s_waitcnt lgkmcnt(0)
    s_barrier
    ds_read_b128 a[64:67], v7 offset:16384
    ds_read_b128 a[68:71], v8 offset:16384
    ds_read_b128 a[72:75], v9 offset:16384
    ds_read_b128 a[76:79], v10 offset:16384
    ds_read_b128 a[80:83], v7 offset:20480
    ds_read_b128 a[84:87], v8 offset:20480
    ds_read_b128 a[88:91], v9 offset:20480
    ds_read_b128 a[92:95], v10 offset:20480
    s_waitcnt vmcnt(8)
    buffer_load_dwordx4 a[144:147], v11, s[48:51], s13 offen offset:0 sc1
    buffer_load_dwordx4 a[148:151], v11, s[48:51], s13 offen offset:1024 sc1
    buffer_load_dwordx4 a[152:155], v11, s[48:51], s13 offen offset:2048 sc1
    buffer_load_dwordx4 a[156:159], v11, s[48:51], s13 offen offset:3072 sc1
    v_perm_b32 v24, v164, v160, s56
    v_perm_b32 v25, v172, v168, s56
    v_lshl_or_b32 v36, v25, 16, v24
    v_perm_b32 v24, v165, v161, s56
    v_perm_b32 v25, v173, v169, s56
    v_lshl_or_b32 v38, v25, 16, v24
    v_perm_b32 v24, v166, v162, s56
    v_perm_b32 v25, v174, v170, s56
    v_lshl_or_b32 v40, v25, 16, v24
    v_perm_b32 v24, v167, v163, s56
    v_perm_b32 v25, v175, v171, s56
    v_lshl_or_b32 v42, v25, 16, v24
    v_dot4c_i32_i8 v44, 0x01010101, v36
    v_dot4c_i32_i8 v45, 0x01010101, v38
    v_dot4c_i32_i8 v46, 0x01010101, v40
    v_dot4c_i32_i8 v47, 0x01010101, v42
    s_waitcnt vmcnt(8)
    buffer_load_dwordx4 a[160:163], v11, s[48:51], s14 offen offset:0 sc1
    buffer_load_dwordx4 a[164:167], v11, s[48:51], s14 offen offset:1024 sc1
    buffer_load_dwordx4 a[168:171], v11, s[48:51], s14 offen offset:2048 sc1
    buffer_load_dwordx4 a[172:175], v11, s[48:51], s14 offen offset:3072 sc1
    v_perm_b32 v24, v180, v176, s56
    v_perm_b32 v25, v188, v184, s56
    v_lshl_or_b32 v37, v25, 16, v24
    v_perm_b32 v24, v181, v177, s56
    v_perm_b32 v25, v189, v185, s56
    v_lshl_or_b32 v39, v25, 16, v24
    buffer_load_dwordx4 a[176:179], v11, s[48:51], s15 offen offset:0 sc1
    v_perm_b32 v24, v182, v178, s56
    v_perm_b32 v25, v190, v186, s56
    v_lshl_or_b32 v41, v25, 16, v24
    v_perm_b32 v24, v183, v179, s56
    v_perm_b32 v25, v191, v187, s56
    v_lshl_or_b32 v43, v25, 16, v24
    buffer_load_dwordx4 a[180:183], v11, s[48:51], s15 offen offset:1024 sc1
    ds_write_b64 v5, v[36:37] offset:24576
    ds_write_b64 v5, v[38:39] offset:24704
    ds_write_b64 v6, v[40:41] offset:24832
    ds_write_b64 v6, v[42:43] offset:24960
    v_dot4c_i32_i8 v44, 0x01010101, v37
    v_dot4c_i32_i8 v45, 0x01010101, v39
    v_dot4c_i32_i8 v46, 0x01010101, v41
    v_dot4c_i32_i8 v47, 0x01010101, v43
    buffer_load_dwordx4 a[184:187], v11, s[48:51], s15 offen offset:2048 sc1
    s_nop 2
    ds_add_u32 v19, v44 offset:32768
    ds_add_u32 v19, v45 offset:32772
    ds_add_u32 v19, v46 offset:32776
    ds_add_u32 v19, v47 offset:32780
    s_waitcnt lgkmcnt(0)
    s_barrier
    ds_read_b128 a[96:99], v7 offset:24576
    ds_read_b128 a[100:103], v8 offset:24576
    ds_read_b128 a[104:107], v9 offset:24576
    ds_read_b128 a[108:111], v10 offset:24576
    ds_read_b128 a[112:115], v7 offset:28672
    ds_read_b128 a[116:119], v8 offset:28672
    ds_read_b128 a[120:123], v9 offset:28672
    ds_read_b128 a[124:127], v10 offset:28672
    ds_read_b128 v[96:99], v20 offset:32768
    ds_read_b128 v[100:103], v20 offset:32784
    buffer_load_dwordx4 a[188:191], v11, s[48:51], s15 offen offset:3072 sc1
L_xloop:
    s_waitcnt vmcnt(15)
    buffer_load_dwordx4 a[192:195], v12, s[48:51], s12 offen offset:0 sc1
    v_mfma_i32_16x16x64_i8 v[48:51], a[0:3], a[128:131], 0
    v_mfma_i32_16x16x64_i8 v[52:55], a[4:7], a[128:131], 0
    s_waitcnt vmcnt(15)
    v_mfma_i32_16x16x64_i8 v[48:51], a[8:11], a[132:135], v[48:51]
    v_mfma_i32_16x16x64_i8 v[52:55], a[12:15], a[132:135], v[52:55]
    s_waitcnt vmcnt(14)
    buffer_load_dwordx4 a[196:199], v12, s[48:51], s12 offen offset:1024 sc1
    v_mfma_i32_16x16x64_i8 v[48:51], a[16:19], a[136:139], v[48:51]
    v_mfma_i32_16x16x64_i8 v[52:55], a[20:23], a[136:139], v[52:55]
    s_waitcnt vmcnt(14)
    v_mfma_i32_16x16x64_i8 v[48:51], a[24:27], a[140:143], v[48:51]
    v_mfma_i32_16x16x64_i8 v[52:55], a[28:31], a[140:143], v[52:55]
    s_waitcnt vmcnt(13)
    buffer_load_dwordx4 a[200:203], v12, s[48:51], s12 offen offset:2048 sc1
    v_mfma_i32_16x16x64_i8 v[48:51], a[32:35], a[144:147], v[48:51]
    v_mfma_i32_16x16x64_i8 v[52:55], a[36:39], a[144:147], v[52:55]
    s_waitcnt vmcnt(13)
    v_mfma_i32_16x16x64_i8 v[48:51], a[40:43], a[148:151], v[48:51]
    v_mfma_i32_16x16x64_i8 v[52:55], a[44:47], a[148:151], v[52:55]
    s_waitcnt vmcnt(12)
    buffer_load_dwordx4 a[204:207], v12, s[48:51], s12 offen offset:3072 sc1
    v_mfma_i32_16x16x64_i8 v[48:51], a[48:51], a[152:155], v[48:51]
    v_mfma_i32_16x16x64_i8 v[52:55], a[52:55], a[152:155], v[52:55]
    s_waitcnt vmcnt(12)
    v_mfma_i32_16x16x64_i8 v[48:51], a[56:59], a[156:159], v[48:51]
    v_mfma_i32_16x16x64_i8 v[52:55], a[60:63], a[156:159], v[52:55]
    s_waitcnt vmcnt(11)
    buffer_load_dwordx4 a[208:211], v12, s[48:51], s13 offen offset:0 sc1
    s_waitcnt lgkmcnt(0)
    v_mfma_i32_16x16x64_i8 v[48:51], a[64:67], a[160:163], v[48:51]
    v_cvt_f32_i32 v96, v96
    v_cvt_f32_i32 v97, v97
    v_cvt_f32_i32 v98, v98
    v_mfma_i32_16x16x64_i8 v[52:55], a[68:71], a[160:163], v[52:55]
    v_cvt_f32_i32 v99, v99
    v_cvt_f32_i32 v100, v100
    v_cvt_f32_i32 v101, v101
    v_cvt_f32_i32 v102, v102
    s_waitcnt vmcnt(11)
    buffer_load_dwordx4 a[212:215], v12, s[48:51], s13 offen offset:1024 sc1
    v_mfma_i32_16x16x64_i8 v[48:51], a[72:75], a[164:167], v[48:51]
    v_cvt_f32_i32 v103, v103
    v_cvt_pk_bf16_f32 v96, 0, v96
    v_cvt_pk_bf16_f32 v97, 0, v97
    v_mfma_i32_16x16x64_i8 v[52:55], a[76:79], a[164:167], v[52:55]
    v_cvt_pk_bf16_f32 v98, 0, v98
    v_cvt_pk_bf16_f32 v99, 0, v99
    v_cvt_pk_bf16_f32 v100, 0, v100
    v_cvt_pk_bf16_f32 v101, 0, v101
    s_waitcnt vmcnt(11)
    buffer_load_dwordx4 a[216:219], v12, s[48:51], s13 offen offset:2048 sc1
    v_mfma_i32_16x16x64_i8 v[48:51], a[80:83], a[168:171], v[48:51]
    v_cvt_pk_bf16_f32 v102, 0, v102
    v_cvt_pk_bf16_f32 v103, 0, v103
    v_mul_f32 v96, v21, v96
    v_mfma_i32_16x16x64_i8 v[52:55], a[84:87], a[168:171], v[52:55]
    v_mul_f32 v97, v21, v97
    v_mul_f32 v98, v21, v98
    v_mul_f32 v99, v21, v99
    v_mul_f32 v100, v21, v100
    s_waitcnt vmcnt(11)
    buffer_load_dwordx4 a[220:223], v12, s[48:51], s13 offen offset:3072 sc1
    v_mfma_i32_16x16x64_i8 v[48:51], a[88:91], a[172:175], v[48:51]
    v_mul_f32 v101, v21, v101
    v_mul_f32 v102, v21, v102
    v_mul_f32 v103, v21, v103
    v_mfma_i32_16x16x64_i8 v[52:55], a[92:95], a[172:175], v[52:55]
    v_cvt_pk_bf16_f32 v96, 0, v96
    v_cvt_pk_bf16_f32 v97, 0, v97
    v_cvt_pk_bf16_f32 v98, 0, v98
    v_cvt_pk_bf16_f32 v99, 0, v99
    s_waitcnt vmcnt(11)
    buffer_load_dwordx4 a[224:227], v12, s[48:51], s14 offen offset:0 sc1
    v_mfma_i32_16x16x64_i8 v[48:51], a[96:99], a[176:179], v[48:51]
    v_cvt_pk_bf16_f32 v100, 0, v100
    v_cvt_pk_bf16_f32 v101, 0, v101
    v_cvt_pk_bf16_f32 v102, 0, v102
    v_mfma_i32_16x16x64_i8 v[52:55], a[100:103], a[176:179], v[52:55]
    v_cvt_pk_bf16_f32 v103, 0, v103
    s_waitcnt vmcnt(11)
    buffer_load_dwordx4 a[228:231], v12, s[48:51], s14 offen offset:1024 sc1
    v_mfma_i32_16x16x64_i8 v[48:51], a[104:107], a[180:183], v[48:51]
    v_mfma_i32_16x16x64_i8 v[52:55], a[108:111], a[180:183], v[52:55]
    s_waitcnt vmcnt(11)
    buffer_load_dwordx4 a[232:235], v12, s[48:51], s14 offen offset:2048 sc1
    v_mfma_i32_16x16x64_i8 v[48:51], a[112:115], a[184:187], v[48:51]
    v_mfma_i32_16x16x64_i8 v[52:55], a[116:119], a[184:187], v[52:55]
    s_waitcnt vmcnt(11)
    buffer_load_dwordx4 a[236:239], v12, s[48:51], s14 offen offset:3072 sc1
    v_mfma_i32_16x16x64_i8 v[48:51], a[120:123], a[188:191], v[48:51]
    v_mfma_i32_16x16x64_i8 v[52:55], a[124:127], a[188:191], v[52:55]
    s_waitcnt vmcnt(11)
    s_add_u32 s79, s62, 256
    s_mov_b32 s16, 0
    s_lshl_b32 s17, s16, 6
    s_and_b32 s17, s17, 0x40
    s_load_dwordx2 s[96:97], s[18:19], s17
    s_load_dwordx2 s[80:81], s[20:21], s79 offset:0
    s_load_dwordx2 s[82:83], s[20:21], s79 offset:128
    s_add_u32 s79, s79, 4096
    s_add_u32 s16, s16, 1
    buffer_load_dwordx4 a[240:243], v12, s[48:51], s15 offen offset:0 sc1
    v_mfma_i32_16x16x64_i8 v[56:59], a[0:3], a[192:195], 0
    v_mfma_i32_16x16x64_i8 v[60:63], a[4:7], a[192:195], 0
    s_waitcnt vmcnt(11)
    buffer_load_dwordx4 a[244:247], v12, s[48:51], s15 offen offset:1024 sc1
    v_mfma_i32_16x16x64_i8 v[56:59], a[8:11], a[196:199], v[56:59]
    v_mfma_i32_16x16x64_i8 v[60:63], a[12:15], a[196:199], v[60:63]
    s_waitcnt vmcnt(11)
    buffer_load_dwordx4 a[248:251], v12, s[48:51], s15 offen offset:2048 sc1
    v_mfma_i32_16x16x64_i8 v[56:59], a[16:19], a[200:203], v[56:59]
    v_mfma_i32_16x16x64_i8 v[60:63], a[20:23], a[200:203], v[60:63]
    s_waitcnt vmcnt(11)
    buffer_load_dwordx4 a[252:255], v12, s[48:51], s15 offen offset:3072 sc1
    v_mfma_i32_16x16x64_i8 v[56:59], a[24:27], a[204:207], v[56:59]
    v_mfma_i32_16x16x64_i8 v[60:63], a[28:31], a[204:207], v[60:63]
    s_waitcnt vmcnt(11)
    s_waitcnt lgkmcnt(0)
    s_cmp_eq_u32 s96, 0
    s_cbranch_scc1 L_fB
    s_cmp_lg_u64 s[80:81], s[96:97]
    s_cbranch_scc1 L_fB
    s_cmp_lg_u64 s[82:83], s[96:97]
    s_cbranch_scc1 L_fB
L_xokB:
    buffer_load_dwordx4 a[128:131], v13, s[48:51], s12 offen offset:0 sc1
    v_mfma_i32_16x16x64_i8 v[56:59], a[32:35], a[208:211], v[56:59]
    v_cvt_f32_i32 v48, v48
    v_cvt_f32_i32 v49, v49
    v_cvt_f32_i32 v50, v50
    v_mfma_i32_16x16x64_i8 v[60:63], a[36:39], a[208:211], v[60:63]
    v_cvt_f32_i32 v51, v51
    v_cvt_f32_i32 v52, v52
    v_cvt_f32_i32 v53, v53
    v_cvt_f32_i32 v54, v54
    s_waitcnt vmcnt(11)
    buffer_load_dwordx4 a[132:135], v13, s[48:51], s12 offen offset:1024 sc1
    v_mfma_i32_16x16x64_i8 v[56:59], a[40:43], a[212:215], v[56:59]
    v_cvt_f32_i32 v55, v55
    v_cvt_pk_bf16_f32 v48, 0, v48
    v_cvt_pk_bf16_f32 v49, 0, v49
    v_mfma_i32_16x16x64_i8 v[60:63], a[44:47], a[212:215], v[60:63]
    v_cvt_pk_bf16_f32 v50, 0, v50
    v_cvt_pk_bf16_f32 v51, 0, v51
    v_cvt_pk_bf16_f32 v52, 0, v52
    v_cvt_pk_bf16_f32 v53, 0, v53
    s_waitcnt vmcnt(11)
    buffer_load_dwordx4 a[136:139], v13, s[48:51], s12 offen offset:2048 sc1
    v_mfma_i32_16x16x64_i8 v[56:59], a[48:51], a[216:219], v[56:59]
    v_cvt_pk_bf16_f32 v54, 0, v54
    v_cvt_pk_bf16_f32 v55, 0, v55
    v_add_f32 v48, v96, v48
    v_mfma_i32_16x16x64_i8 v[60:63], a[52:55], a[216:219], v[60:63]
    v_add_f32 v49, v97, v49
    v_add_f32 v50, v98, v50
    v_add_f32 v51, v99, v51
    v_add_f32 v52, v100, v52
    s_waitcnt vmcnt(11)
    buffer_load_dwordx4 a[140:143], v13, s[48:51], s12 offen offset:3072 sc1
    v_mfma_i32_16x16x64_i8 v[56:59], a[56:59], a[220:223], v[56:59]
    v_add_f32 v53, v101, v53
    v_add_f32 v54, v102, v54
    v_add_f32 v55, v103, v55
    v_mfma_i32_16x16x64_i8 v[60:63], a[60:63], a[220:223], v[60:63]
    v_cvt_pk_bf16_f32 v48, 0, v48
    v_cvt_pk_bf16_f32 v49, 0, v49
    v_cvt_pk_bf16_f32 v50, 0, v50
    v_cvt_pk_bf16_f32 v51, 0, v51
    s_waitcnt vmcnt(11)
    buffer_load_dwordx4 a[144:147], v13, s[48:51], s13 offen offset:0 sc1
    v_mfma_i32_16x16x64_i8 v[56:59], a[64:67], a[224:227], v[56:59]
    v_cvt_pk_bf16_f32 v52, 0, v52
    v_cvt_pk_bf16_f32 v53, 0, v53
    v_cvt_pk_bf16_f32 v54, 0, v54
    v_mfma_i32_16x16x64_i8 v[60:63], a[68:71], a[224:227], v[60:63]
    v_cvt_pk_bf16_f32 v55, 0, v55
    v_mul_f32 v48, s58, v48
    v_mul_f32 v49, s58, v49
    v_mul_f32 v50, s58, v50
    s_waitcnt vmcnt(11)
    buffer_load_dwordx4 a[148:151], v13, s[48:51], s13 offen offset:1024 sc1
    v_mfma_i32_16x16x64_i8 v[56:59], a[72:75], a[228:231], v[56:59]
    v_mul_f32 v51, s58, v51
    v_mul_f32 v52, s58, v52
    v_mul_f32 v53, s58, v53
    v_mfma_i32_16x16x64_i8 v[60:63], a[76:79], a[228:231], v[60:63]
    v_mul_f32 v54, s58, v54
    v_mul_f32 v55, s58, v55
    v_cvt_pk_bf16_f32 v48, 0, v48
    v_cvt_pk_bf16_f32 v49, 0, v49
    s_waitcnt vmcnt(11)
    buffer_load_dwordx4 a[152:155], v13, s[48:51], s13 offen offset:2048 sc1
    v_mfma_i32_16x16x64_i8 v[56:59], a[80:83], a[232:235], v[56:59]
    v_cvt_pk_bf16_f32 v50, 0, v50
    v_cvt_pk_bf16_f32 v51, 0, v51
    v_cvt_pk_bf16_f32 v52, 0, v52
    v_mfma_i32_16x16x64_i8 v[60:63], a[84:87], a[232:235], v[60:63]
    v_cvt_pk_bf16_f32 v53, 0, v53
    v_cvt_pk_bf16_f32 v54, 0, v54
    v_cvt_pk_bf16_f32 v55, 0, v55
    v_mul_f32 v48, v80, v48
    s_waitcnt vmcnt(11)
    buffer_load_dwordx4 a[156:159], v13, s[48:51], s13 offen offset:3072 sc1
    v_mfma_i32_16x16x64_i8 v[56:59], a[88:91], a[236:239], v[56:59]
    v_mul_f32 v49, v81, v49
    v_mul_f32 v50, v82, v50
    v_mul_f32 v51, v83, v51
    v_mfma_i32_16x16x64_i8 v[60:63], a[92:95], a[236:239], v[60:63]
    v_mul_f32 v52, v84, v52
    v_mul_f32 v53, v85, v53
    v_mul_f32 v54, v86, v54
    v_mul_f32 v55, v87, v55
    s_waitcnt vmcnt(11)
    buffer_load_dwordx4 a[160:163], v13, s[48:51], s14 offen offset:0 sc1
    v_mfma_i32_16x16x64_i8 v[56:59], a[96:99], a[240:243], v[56:59]
    v_cvt_pk_bf16_f32 v48, 0, v48
    v_cvt_pk_bf16_f32 v49, 0, v49
    v_cvt_pk_bf16_f32 v50, 0, v50
    v_mfma_i32_16x16x64_i8 v[60:63], a[100:103], a[240:243], v[60:63]
    v_cvt_pk_bf16_f32 v51, 0, v51
    v_cvt_pk_bf16_f32 v52, 0, v52
    v_cvt_pk_bf16_f32 v53, 0, v53
    v_cvt_pk_bf16_f32 v54, 0, v54
    s_waitcnt vmcnt(11)
    buffer_load_dwordx4 a[164:167], v13, s[48:51], s14 offen offset:1024 sc1
    v_mfma_i32_16x16x64_i8 v[56:59], a[104:107], a[244:247], v[56:59]
    v_cvt_pk_bf16_f32 v55, 0, v55
    v_add_f32 v48, v88, v48
    v_add_f32 v49, v89, v49
    v_mfma_i32_16x16x64_i8 v[60:63], a[108:111], a[244:247], v[60:63]
    v_add_f32 v50, v90, v50
    v_add_f32 v51, v91, v51
    v_add_f32 v52, v92, v52
    v_add_f32 v53, v93, v53
    s_waitcnt vmcnt(11)
    buffer_load_dwordx4 a[168:171], v13, s[48:51], s14 offen offset:2048 sc1
    v_mfma_i32_16x16x64_i8 v[56:59], a[112:115], a[248:251], v[56:59]
    v_add_f32 v54, v94, v54
    v_add_f32 v55, v95, v55
    v_cvt_pk_bf16_f32 v112, v48, v49
    v_mfma_i32_16x16x64_i8 v[60:63], a[116:119], a[248:251], v[60:63]
    v_cvt_pk_bf16_f32 v113, v50, v51
    v_cvt_pk_bf16_f32 v114, v52, v53
    v_cvt_pk_bf16_f32 v115, v54, v55
    s_waitcnt vmcnt(11)
    buffer_load_dwordx4 a[172:175], v13, s[48:51], s14 offen offset:3072 sc1
    v_mfma_i32_16x16x64_i8 v[56:59], a[120:123], a[252:255], v[56:59]
    v_mfma_i32_16x16x64_i8 v[60:63], a[124:127], a[252:255], v[60:63]
    s_waitcnt vmcnt(11)
    buffer_load_dwordx4 a[176:179], v13, s[48:51], s15 offen offset:0 sc1
    v_mfma_i32_16x16x64_i8 v[64:67], a[0:3], a[128:131], 0
    v_mfma_i32_16x16x64_i8 v[68:71], a[4:7], a[128:131], 0
    s_waitcnt vmcnt(11)
    buffer_load_dwordx4 a[180:183], v13, s[48:51], s15 offen offset:1024 sc1
    v_mfma_i32_16x16x64_i8 v[64:67], a[8:11], a[132:135], v[64:67]
    v_mfma_i32_16x16x64_i8 v[68:71], a[12:15], a[132:135], v[68:71]
    s_waitcnt vmcnt(11)
    buffer_load_dwordx4 a[184:187], v13, s[48:51], s15 offen offset:2048 sc1
    v_mfma_i32_16x16x64_i8 v[64:67], a[16:19], a[136:139], v[64:67]
    v_mfma_i32_16x16x64_i8 v[68:71], a[20:23], a[136:139], v[68:71]
    s_waitcnt vmcnt(11)
    buffer_load_dwordx4 a[188:191], v13, s[48:51], s15 offen offset:3072 sc1
    v_mfma_i32_16x16x64_i8 v[64:67], a[24:27], a[140:143], v[64:67]
    v_mfma_i32_16x16x64_i8 v[68:71], a[28:31], a[140:143], v[68:71]
    s_waitcnt vmcnt(11)
    buffer_load_dwordx4 a[192:195], v14, s[48:51], s12 offen offset:0 sc1
    v_mfma_i32_16x16x64_i8 v[64:67], a[32:35], a[144:147], v[64:67]
    v_cvt_f32_i32 v56, v56
    v_cvt_f32_i32 v57, v57
    v_cvt_f32_i32 v58, v58
    v_mfma_i32_16x16x64_i8 v[68:71], a[36:39], a[144:147], v[68:71]
    v_cvt_f32_i32 v59, v59
    v_cvt_f32_i32 v60, v60
    v_cvt_f32_i32 v61, v61
    v_cvt_f32_i32 v62, v62
    s_waitcnt vmcnt(11)
    buffer_load_dwordx4 a[196:199], v14, s[48:51], s12 offen offset:1024 sc1
    v_mfma_i32_16x16x64_i8 v[64:67], a[40:43], a[148:151], v[64:67]
    v_cvt_f32_i32 v63, v63
    v_cvt_pk_bf16_f32 v56, 0, v56
    v_cvt_pk_bf16_f32 v57, 0, v57
    v_mfma_i32_16x16x64_i8 v[68:71], a[44:47], a[148:151], v[68:71]
    v_cvt_pk_bf16_f32 v58, 0, v58
    v_cvt_pk_bf16_f32 v59, 0, v59
    v_cvt_pk_bf16_f32 v60, 0, v60
    v_cvt_pk_bf16_f32 v61, 0, v61
    s_waitcnt vmcnt(11)
    buffer_load_dwordx4 a[200:203], v14, s[48:51], s12 offen offset:2048 sc1
    v_mfma_i32_16x16x64_i8 v[64:67], a[48:51], a[152:155], v[64:67]
    v_cvt_pk_bf16_f32 v62, 0, v62
    v_cvt_pk_bf16_f32 v63, 0, v63
    v_add_f32 v56, v96, v56
    v_mfma_i32_16x16x64_i8 v[68:71], a[52:55], a[152:155], v[68:71]
    v_add_f32 v57, v97, v57
    v_add_f32 v58, v98, v58
    v_add_f32 v59, v99, v59
    v_add_f32 v60, v100, v60
    s_waitcnt vmcnt(11)
    buffer_load_dwordx4 a[204:207], v14, s[48:51], s12 offen offset:3072 sc1
    v_mfma_i32_16x16x64_i8 v[64:67], a[56:59], a[156:159], v[64:67]
    v_add_f32 v61, v101, v61
    v_add_f32 v62, v102, v62
    v_add_f32 v63, v103, v63
    v_mfma_i32_16x16x64_i8 v[68:71], a[60:63], a[156:159], v[68:71]
    v_cvt_pk_bf16_f32 v56, 0, v56
    v_cvt_pk_bf16_f32 v57, 0, v57
    v_cvt_pk_bf16_f32 v58, 0, v58
    v_cvt_pk_bf16_f32 v59, 0, v59
    s_waitcnt vmcnt(11)
    buffer_load_dwordx4 a[208:211], v14, s[48:51], s13 offen offset:0 sc1
    v_mfma_i32_16x16x64_i8 v[64:67], a[64:67], a[160:163], v[64:67]
    v_cvt_pk_bf16_f32 v60, 0, v60
    v_cvt_pk_bf16_f32 v61, 0, v61
    v_cvt_pk_bf16_f32 v62, 0, v62
    v_mfma_i32_16x16x64_i8 v[68:71], a[68:71], a[160:163], v[68:71]
    v_cvt_pk_bf16_f32 v63, 0, v63
    v_mul_f32 v56, s58, v56
    v_mul_f32 v57, s58, v57
    v_mul_f32 v58, s58, v58
    s_waitcnt vmcnt(11)
    buffer_load_dwordx4 a[212:215], v14, s[48:51], s13 offen offset:1024 sc1
    v_mfma_i32_16x16x64_i8 v[64:67], a[72:75], a[164:167], v[64:67]
    v_mul_f32 v59, s58, v59
    v_mul_f32 v60, s58, v60
    v_mul_f32 v61, s58, v61
    v_mfma_i32_16x16x64_i8 v[68:71], a[76:79], a[164:167], v[68:71]
    v_mul_f32 v62, s58, v62
    v_mul_f32 v63, s58, v63
    v_cvt_pk_bf16_f32 v56, 0, v56
    v_cvt_pk_bf16_f32 v57, 0, v57
    s_waitcnt vmcnt(11)
    buffer_load_dwordx4 a[216:219], v14, s[48:51], s13 offen offset:2048 sc1
    v_mfma_i32_16x16x64_i8 v[64:67], a[80:83], a[168:171], v[64:67]
    v_cvt_pk_bf16_f32 v58, 0, v58
    v_cvt_pk_bf16_f32 v59, 0, v59
    v_cvt_pk_bf16_f32 v60, 0, v60
    v_mfma_i32_16x16x64_i8 v[68:71], a[84:87], a[168:171], v[68:71]
    v_cvt_pk_bf16_f32 v61, 0, v61
    v_cvt_pk_bf16_f32 v62, 0, v62
    v_cvt_pk_bf16_f32 v63, 0, v63
    v_mul_f32 v56, v80, v56
    s_waitcnt vmcnt(11)
    buffer_load_dwordx4 a[220:223], v14, s[48:51], s13 offen offset:3072 sc1
    v_mfma_i32_16x16x64_i8 v[64:67], a[88:91], a[172:175], v[64:67]
    v_mul_f32 v57, v81, v57
    v_mul_f32 v58, v82, v58
    v_mul_f32 v59, v83, v59
    v_mfma_i32_16x16x64_i8 v[68:71], a[92:95], a[172:175], v[68:71]
    v_mul_f32 v60, v84, v60
    v_mul_f32 v61, v85, v61
    v_mul_f32 v62, v86, v62
    v_mul_f32 v63, v87, v63
    s_waitcnt vmcnt(11)
    buffer_load_dwordx4 a[224:227], v14, s[48:51], s14 offen offset:0 sc1
    v_mfma_i32_16x16x64_i8 v[64:67], a[96:99], a[176:179], v[64:67]
    v_cvt_pk_bf16_f32 v56, 0, v56
    v_cvt_pk_bf16_f32 v57, 0, v57
    v_cvt_pk_bf16_f32 v58, 0, v58
    v_mfma_i32_16x16x64_i8 v[68:71], a[100:103], a[176:179], v[68:71]
    v_cvt_pk_bf16_f32 v59, 0, v59
    v_cvt_pk_bf16_f32 v60, 0, v60
    v_cvt_pk_bf16_f32 v61, 0, v61
    v_cvt_pk_bf16_f32 v62, 0, v62
    s_waitcnt vmcnt(11)
    buffer_load_dwordx4 a[228:231], v14, s[48:51], s14 offen offset:1024 sc1
    v_mfma_i32_16x16x64_i8 v[64:67], a[104:107], a[180:183], v[64:67]
    v_cvt_pk_bf16_f32 v63, 0, v63
    v_add_f32 v56, v88, v56
    v_add_f32 v57, v89, v57
    v_mfma_i32_16x16x64_i8 v[68:71], a[108:111], a[180:183], v[68:71]
    v_add_f32 v58, v90, v58
    v_add_f32 v59, v91, v59
    v_add_f32 v60, v92, v60
    v_add_f32 v61, v93, v61
    s_waitcnt vmcnt(11)
    buffer_load_dwordx4 a[232:235], v14, s[48:51], s14 offen offset:2048 sc1
    v_mfma_i32_16x16x64_i8 v[64:67], a[112:115], a[184:187], v[64:67]
    v_add_f32 v62, v94, v62
    v_add_f32 v63, v95, v63
    v_cvt_pk_bf16_f32 v116, v56, v57
    v_mfma_i32_16x16x64_i8 v[68:71], a[116:119], a[184:187], v[68:71]
    v_cvt_pk_bf16_f32 v117, v58, v59
    v_cvt_pk_bf16_f32 v118, v60, v61
    v_cvt_pk_bf16_f32 v119, v62, v63
    s_waitcnt vmcnt(11)
    buffer_load_dwordx4 a[236:239], v14, s[48:51], s14 offen offset:3072 sc1
    v_mfma_i32_16x16x64_i8 v[64:67], a[120:123], a[188:191], v[64:67]
    v_mfma_i32_16x16x64_i8 v[68:71], a[124:127], a[188:191], v[68:71]
    s_waitcnt vmcnt(11)
    buffer_load_dwordx4 a[240:243], v14, s[48:51], s15 offen offset:0 sc1
    v_mfma_i32_16x16x64_i8 v[72:75], a[0:3], a[192:195], 0
    v_mfma_i32_16x16x64_i8 v[76:79], a[4:7], a[192:195], 0
    s_waitcnt vmcnt(11)
    buffer_load_dwordx4 a[244:247], v14, s[48:51], s15 offen offset:1024 sc1
    v_mfma_i32_16x16x64_i8 v[72:75], a[8:11], a[196:199], v[72:75]
    v_mfma_i32_16x16x64_i8 v[76:79], a[12:15], a[196:199], v[76:79]
    s_waitcnt vmcnt(11)
    buffer_load_dwordx4 a[248:251], v14, s[48:51], s15 offen offset:2048 sc1
    v_mfma_i32_16x16x64_i8 v[72:75], a[16:19], a[200:203], v[72:75]
    v_mfma_i32_16x16x64_i8 v[76:79], a[20:23], a[200:203], v[76:79]
    s_waitcnt vmcnt(11)
    buffer_load_dwordx4 a[252:255], v14, s[48:51], s15 offen offset:3072 sc1
    v_mfma_i32_16x16x64_i8 v[72:75], a[24:27], a[204:207], v[72:75]
    v_mfma_i32_16x16x64_i8 v[76:79], a[28:31], a[204:207], v[76:79]
    buffer_store_dwordx4 v[112:115], v15, s[32:35], s4 offen sc1
    s_waitcnt vmcnt(12)
    v_mfma_i32_16x16x64_i8 v[72:75], a[32:35], a[208:211], v[72:75]
    v_cvt_f32_i32 v64, v64
    v_cvt_f32_i32 v65, v65
    v_cvt_f32_i32 v66, v66
    v_mfma_i32_16x16x64_i8 v[76:79], a[36:39], a[208:211], v[76:79]
    v_cvt_f32_i32 v67, v67
    v_cvt_f32_i32 v68, v68
    v_cvt_f32_i32 v69, v69
    v_cvt_f32_i32 v70, v70
    buffer_store_dwordx4 v[116:119], v15, s[32:35], s5 offen sc1
    s_waitcnt vmcnt(12)
    v_mfma_i32_16x16x64_i8 v[72:75], a[40:43], a[212:215], v[72:75]
    v_cvt_f32_i32 v71, v71
    v_cvt_pk_bf16_f32 v64, 0, v64
    v_cvt_pk_bf16_f32 v65, 0, v65
    v_mfma_i32_16x16x64_i8 v[76:79], a[44:47], a[212:215], v[76:79]
    v_cvt_pk_bf16_f32 v66, 0, v66
    v_cvt_pk_bf16_f32 v67, 0, v67
    v_cvt_pk_bf16_f32 v68, 0, v68
    v_cvt_pk_bf16_f32 v69, 0, v69
    s_waitcnt vmcnt(11)
    v_mfma_i32_16x16x64_i8 v[72:75], a[48:51], a[216:219], v[72:75]
    v_cvt_pk_bf16_f32 v70, 0, v70
    v_cvt_pk_bf16_f32 v71, 0, v71
    v_add_f32 v64, v96, v64
    v_mfma_i32_16x16x64_i8 v[76:79], a[52:55], a[216:219], v[76:79]
    v_add_f32 v65, v97, v65
    v_add_f32 v66, v98, v66
    v_add_f32 v67, v99, v67
    v_add_f32 v68, v100, v68
    s_waitcnt vmcnt(10)
    v_mfma_i32_16x16x64_i8 v[72:75], a[56:59], a[220:223], v[72:75]
    v_add_f32 v69, v101, v69
    v_add_f32 v70, v102, v70
    v_add_f32 v71, v103, v71
    v_mfma_i32_16x16x64_i8 v[76:79], a[60:63], a[220:223], v[76:79]
    v_cvt_pk_bf16_f32 v64, 0, v64
    v_cvt_pk_bf16_f32 v65, 0, v65
    v_cvt_pk_bf16_f32 v66, 0, v66
    v_cvt_pk_bf16_f32 v67, 0, v67
    s_waitcnt vmcnt(9)
    v_mfma_i32_16x16x64_i8 v[72:75], a[64:67], a[224:227], v[72:75]
    v_cvt_pk_bf16_f32 v68, 0, v68
    v_cvt_pk_bf16_f32 v69, 0, v69
    v_cvt_pk_bf16_f32 v70, 0, v70
    v_mfma_i32_16x16x64_i8 v[76:79], a[68:71], a[224:227], v[76:79]
    v_cvt_pk_bf16_f32 v71, 0, v71
    v_mul_f32 v64, s58, v64
    v_mul_f32 v65, s58, v65
    v_mul_f32 v66, s58, v66
    s_waitcnt vmcnt(8)
    v_mfma_i32_16x16x64_i8 v[72:75], a[72:75], a[228:231], v[72:75]
    v_mul_f32 v67, s58, v67
    v_mul_f32 v68, s58, v68
    v_mul_f32 v69, s58, v69
    v_mfma_i32_16x16x64_i8 v[76:79], a[76:79], a[228:231], v[76:79]
    v_mul_f32 v70, s58, v70
    v_mul_f32 v71, s58, v71
    v_cvt_pk_bf16_f32 v64, 0, v64
    v_cvt_pk_bf16_f32 v65, 0, v65
    s_waitcnt vmcnt(7)
    v_mfma_i32_16x16x64_i8 v[72:75], a[80:83], a[232:235], v[72:75]
    v_cvt_pk_bf16_f32 v66, 0, v66
    v_cvt_pk_bf16_f32 v67, 0, v67
    v_cvt_pk_bf16_f32 v68, 0, v68
    v_mfma_i32_16x16x64_i8 v[76:79], a[84:87], a[232:235], v[76:79]
    v_cvt_pk_bf16_f32 v69, 0, v69
    v_cvt_pk_bf16_f32 v70, 0, v70
    v_cvt_pk_bf16_f32 v71, 0, v71
    v_mul_f32 v64, v80, v64
    s_waitcnt vmcnt(6)
    v_mfma_i32_16x16x64_i8 v[72:75], a[88:91], a[236:239], v[72:75]
    v_mul_f32 v65, v81, v65
    v_mul_f32 v66, v82, v66
    v_mul_f32 v67, v83, v67
    v_mfma_i32_16x16x64_i8 v[76:79], a[92:95], a[236:239], v[76:79]
    v_mul_f32 v68, v84, v68
    v_mul_f32 v69, v85, v69
    v_mul_f32 v70, v86, v70
    v_mul_f32 v71, v87, v71
    s_waitcnt vmcnt(5)
    v_mfma_i32_16x16x64_i8 v[72:75], a[96:99], a[240:243], v[72:75]
    v_cvt_pk_bf16_f32 v64, 0, v64
    v_cvt_pk_bf16_f32 v65, 0, v65
    v_cvt_pk_bf16_f32 v66, 0, v66
    v_mfma_i32_16x16x64_i8 v[76:79], a[100:103], a[240:243], v[76:79]
    v_cvt_pk_bf16_f32 v67, 0, v67
    v_cvt_pk_bf16_f32 v68, 0, v68
    v_cvt_pk_bf16_f32 v69, 0, v69
    v_cvt_pk_bf16_f32 v70, 0, v70
    s_waitcnt vmcnt(4)
    v_mfma_i32_16x16x64_i8 v[72:75], a[104:107], a[244:247], v[72:75]
    v_cvt_pk_bf16_f32 v71, 0, v71
    v_add_f32 v64, v88, v64
    v_add_f32 v65, v89, v65
    v_mfma_i32_16x16x64_i8 v[76:79], a[108:111], a[244:247], v[76:79]
    v_add_f32 v66, v90, v66
    v_add_f32 v67, v91, v67
    v_add_f32 v68, v92, v68
    v_add_f32 v69, v93, v69
    s_waitcnt vmcnt(3)
    v_mfma_i32_16x16x64_i8 v[72:75], a[112:115], a[248:251], v[72:75]
    v_add_f32 v70, v94, v70
    v_add_f32 v71, v95, v71
    v_cvt_pk_bf16_f32 v120, v64, v65
    v_mfma_i32_16x16x64_i8 v[76:79], a[116:119], a[248:251], v[76:79]
    v_cvt_pk_bf16_f32 v121, v66, v67
    v_cvt_pk_bf16_f32 v122, v68, v69
    v_cvt_pk_bf16_f32 v123, v70, v71
    buffer_store_dwordx4 v[120:123], v15, s[32:35], s6 offen sc1
    s_waitcnt vmcnt(3)
    v_mfma_i32_16x16x64_i8 v[72:75], a[120:123], a[252:255], v[72:75]
    v_mfma_i32_16x16x64_i8 v[76:79], a[124:127], a[252:255], v[76:79]
    s_nop 7
    v_cvt_f32_i32 v72, v72
    v_cvt_f32_i32 v73, v73
    v_cvt_f32_i32 v74, v74
    v_cvt_f32_i32 v75, v75
    v_cvt_f32_i32 v76, v76
    v_cvt_f32_i32 v77, v77
    v_cvt_f32_i32 v78, v78
    v_cvt_f32_i32 v79, v79
    v_cvt_pk_bf16_f32 v72, 0, v72
    v_cvt_pk_bf16_f32 v73, 0, v73
    v_cvt_pk_bf16_f32 v74, 0, v74
    v_cvt_pk_bf16_f32 v75, 0, v75
    v_cvt_pk_bf16_f32 v76, 0, v76
    v_cvt_pk_bf16_f32 v77, 0, v77
    v_cvt_pk_bf16_f32 v78, 0, v78
    v_cvt_pk_bf16_f32 v79, 0, v79
    v_pk_add_f32 v[72:73], v[72:73], v[96:97]
    v_pk_add_f32 v[74:75], v[74:75], v[98:99]
    v_pk_add_f32 v[76:77], v[76:77], v[100:101]
    v_pk_add_f32 v[78:79], v[78:79], v[102:103]
    v_cvt_pk_bf16_f32 v72, 0, v72
    v_cvt_pk_bf16_f32 v73, 0, v73
    v_cvt_pk_bf16_f32 v74, 0, v74
    v_cvt_pk_bf16_f32 v75, 0, v75
    v_cvt_pk_bf16_f32 v76, 0, v76
    v_cvt_pk_bf16_f32 v77, 0, v77
    v_cvt_pk_bf16_f32 v78, 0, v78
    v_cvt_pk_bf16_f32 v79, 0, v79
    v_pk_mul_f32 v[72:73], v[72:73], s[58:59]
    v_pk_mul_f32 v[74:75], v[74:75], s[58:59]
    v_pk_mul_f32 v[76:77], v[76:77], s[58:59]
    v_pk_mul_f32 v[78:79], v[78:79], s[58:59]
    v_cvt_pk_bf16_f32 v72, 0, v72
    v_cvt_pk_bf16_f32 v73, 0, v73
    v_cvt_pk_bf16_f32 v74, 0, v74
    v_cvt_pk_bf16_f32 v75, 0, v75
    v_cvt_pk_bf16_f32 v76, 0, v76
    v_cvt_pk_bf16_f32 v77, 0, v77
    v_cvt_pk_bf16_f32 v78, 0, v78
    v_cvt_pk_bf16_f32 v79, 0, v79
    v_pk_mul_f32 v[72:73], v[72:73], v[80:81]
    v_pk_mul_f32 v[74:75], v[74:75], v[82:83]
    v_pk_mul_f32 v[76:77], v[76:77], v[84:85]
    v_pk_mul_f32 v[78:79], v[78:79], v[86:87]
    v_cvt_pk_bf16_f32 v72, 0, v72
    v_cvt_pk_bf16_f32 v73, 0, v73
    v_cvt_pk_bf16_f32 v74, 0, v74
    v_cvt_pk_bf16_f32 v75, 0, v75
    v_cvt_pk_bf16_f32 v76, 0, v76
    v_cvt_pk_bf16_f32 v77, 0, v77
    v_cvt_pk_bf16_f32 v78, 0, v78
    v_cvt_pk_bf16_f32 v79, 0, v79
    v_pk_add_f32 v[72:73], v[72:73], v[88:89]
    v_pk_add_f32 v[74:75], v[74:75], v[90:91]
    v_pk_add_f32 v[76:77], v[76:77], v[92:93]
    v_pk_add_f32 v[78:79], v[78:79], v[94:95]
    v_cvt_pk_bf16_f32 v124, v72, v73
    v_cvt_pk_bf16_f32 v125, v74, v75
    v_cvt_pk_bf16_f32 v126, v76, v77
    v_cvt_pk_bf16_f32 v127, v78, v79
    buffer_store_dwordx4 v[124:127], v15, s[32:35], s7 offen sc1
    s_endpgm
L_fail5:
    s_waitcnt lgkmcnt(0)
    s_barrier
    ds_read_b128 a[64:67], v7 offset:16384
    ds_read_b128 a[68:71], v8 offset:16384
    ds_read_b128 a[72:75], v9 offset:16384
    ds_read_b128 a[76:79], v10 offset:16384
    ds_read_b128 a[80:83], v7 offset:20480
    ds_read_b128 a[84:87], v8 offset:20480
    ds_read_b128 a[88:91], v9 offset:20480
    ds_read_b128 a[92:95], v10 offset:20480
    s_waitcnt vmcnt(4)
    s_lshl_b32 s17, s16, 6
    s_and_b32 s17, s17, 0x40
    s_load_dwordx2 s[96:97], s[18:19], s17
    s_load_dwordx2 s[80:81], s[20:21], s79 offset:0
    s_load_dwordx2 s[82:83], s[20:21], s79 offset:128
    s_add_u32 s79, s79, 4096
    s_add_u32 s16, s16, 1
    v_perm_b32 v24, v164, v160, s56
    v_perm_b32 v25, v172, v168, s56
    v_lshl_or_b32 v36, v25, 16, v24
    v_perm_b32 v24, v165, v161, s56
    v_perm_b32 v25, v173, v169, s56
    v_lshl_or_b32 v38, v25, 16, v24
    v_perm_b32 v24, v166, v162, s56
    v_perm_b32 v25, v174, v170, s56
    v_lshl_or_b32 v40, v25, 16, v24
    v_perm_b32 v24, v167, v163, s56
    v_perm_b32 v25, v175, v171, s56
    v_lshl_or_b32 v42, v25, 16, v24
    v_dot4c_i32_i8 v44, 0x01010101, v36
    v_dot4c_i32_i8 v45, 0x01010101, v38
    v_dot4c_i32_i8 v46, 0x01010101, v40
    v_dot4c_i32_i8 v47, 0x01010101, v42
    s_waitcnt lgkmcnt(0)
    s_cmp_eq_u32 s96, 0
    s_cbranch_scc1 L_fail6
    s_cmp_lg_u64 s[80:81], s[96:97]
    s_cbranch_scc1 L_fail6
    s_cmp_lg_u64 s[82:83], s[96:97]
    s_cbranch_scc1 L_fail6
    buffer_load_dwordx4 a[128:131], v11, s[48:51], s12 offen offset:0 sc1
    buffer_load_dwordx4 a[132:135], v11, s[48:51], s12 offen offset:1024 sc1
    buffer_load_dwordx4 a[136:139], v11, s[48:51], s12 offen offset:2048 sc1
    buffer_load_dwordx4 a[140:143], v11, s[48:51], s12 offen offset:3072 sc1
    buffer_load_dwordx4 a[144:147], v11, s[48:51], s13 offen offset:0 sc1
    buffer_load_dwordx4 a[148:151], v11, s[48:51], s13 offen offset:1024 sc1
    buffer_load_dwordx4 a[152:155], v11, s[48:51], s13 offen offset:2048 sc1
    buffer_load_dwordx4 a[156:159], v11, s[48:51], s13 offen offset:3072 sc1
    s_waitcnt vmcnt(8)
    buffer_load_dwordx4 a[160:163], v11, s[48:51], s14 offen offset:0 sc1
    buffer_load_dwordx4 a[164:167], v11, s[48:51], s14 offen offset:1024 sc1
    buffer_load_dwordx4 a[168:171], v11, s[48:51], s14 offen offset:2048 sc1
    buffer_load_dwordx4 a[172:175], v11, s[48:51], s14 offen offset:3072 sc1
    v_perm_b32 v24, v180, v176, s56
    v_perm_b32 v25, v188, v184, s56
    v_lshl_or_b32 v37, v25, 16, v24
    v_perm_b32 v24, v181, v177, s56
    v_perm_b32 v25, v189, v185, s56
    v_lshl_or_b32 v39, v25, 16, v24
    buffer_load_dwordx4 a[176:179], v11, s[48:51], s15 offen offset:0 sc1
    v_perm_b32 v24, v182, v178, s56
    v_perm_b32 v25, v190, v186, s56
    v_lshl_or_b32 v41, v25, 16, v24
    v_perm_b32 v24, v183, v179, s56
    v_perm_b32 v25, v191, v187, s56
    v_lshl_or_b32 v43, v25, 16, v24
    buffer_load_dwordx4 a[180:183], v11, s[48:51], s15 offen offset:1024 sc1
    ds_write_b64 v5, v[36:37] offset:24576
    ds_write_b64 v5, v[38:39] offset:24704
    ds_write_b64 v6, v[40:41] offset:24832
    ds_write_b64 v6, v[42:43] offset:24960
    v_dot4c_i32_i8 v44, 0x01010101, v37
    v_dot4c_i32_i8 v45, 0x01010101, v39
    v_dot4c_i32_i8 v46, 0x01010101, v41
    v_dot4c_i32_i8 v47, 0x01010101, v43
    buffer_load_dwordx4 a[184:187], v11, s[48:51], s15 offen offset:2048 sc1
    s_nop 2
    ds_add_u32 v19, v44 offset:32768
    ds_add_u32 v19, v45 offset:32772
    ds_add_u32 v19, v46 offset:32776
    ds_add_u32 v19, v47 offset:32780
    s_waitcnt lgkmcnt(0)
    s_barrier
    ds_read_b128 a[96:99], v7 offset:24576
    ds_read_b128 a[100:103], v8 offset:24576
    ds_read_b128 a[104:107], v9 offset:24576
    ds_read_b128 a[108:111], v10 offset:24576
    ds_read_b128 a[112:115], v7 offset:28672
    ds_read_b128 a[116:119], v8 offset:28672
    ds_read_b128 a[120:123], v9 offset:28672
    ds_read_b128 a[124:127], v10 offset:28672
    ds_read_b128 v[96:99], v20 offset:32768
    ds_read_b128 v[100:103], v20 offset:32784
    buffer_load_dwordx4 a[188:191], v11, s[48:51], s15 offen offset:3072 sc1
    s_branch L_xloop
L_fail6:
    s_waitcnt vmcnt(0)
    s_lshl_b32 s17, s16, 6
    s_and_b32 s17, s17, 0x40
    s_load_dwordx2 s[96:97], s[18:19], s17
    s_load_dwordx2 s[80:81], s[20:21], s79 offset:0
    s_load_dwordx2 s[82:83], s[20:21], s79 offset:128
    s_add_u32 s79, s79, 4096
    s_add_u32 s16, s16, 1
    v_perm_b32 v24, v180, v176, s56
    v_perm_b32 v25, v188, v184, s56
    v_lshl_or_b32 v37, v25, 16, v24
    v_perm_b32 v24, v181, v177, s56
    v_perm_b32 v25, v189, v185, s56
    v_lshl_or_b32 v39, v25, 16, v24
    v_perm_b32 v24, v182, v178, s56
    v_perm_b32 v25, v190, v186, s56
    v_lshl_or_b32 v41, v25, 16, v24
    v_perm_b32 v24, v183, v179, s56
    v_perm_b32 v25, v191, v187, s56
    v_lshl_or_b32 v43, v25, 16, v24
    ds_write_b64 v5, v[36:37] offset:24576
    ds_write_b64 v5, v[38:39] offset:24704
    ds_write_b64 v6, v[40:41] offset:24832
    ds_write_b64 v6, v[42:43] offset:24960
    v_dot4c_i32_i8 v44, 0x01010101, v37
    v_dot4c_i32_i8 v45, 0x01010101, v39
    v_dot4c_i32_i8 v46, 0x01010101, v41
    v_dot4c_i32_i8 v47, 0x01010101, v43
    s_nop 2
    ds_add_u32 v19, v44 offset:32768
    ds_add_u32 v19, v45 offset:32772
    ds_add_u32 v19, v46 offset:32776
    ds_add_u32 v19, v47 offset:32780
    s_waitcnt lgkmcnt(0)
    s_cmp_eq_u32 s96, 0
    s_cbranch_scc1 L_fail7
    s_cmp_lg_u64 s[80:81], s[96:97]
    s_cbranch_scc1 L_fail7
    s_cmp_lg_u64 s[82:83], s[96:97]
    s_cbranch_scc1 L_fail7
    buffer_load_dwordx4 a[128:131], v11, s[48:51], s12 offen offset:0 sc1
    buffer_load_dwordx4 a[132:135], v11, s[48:51], s12 offen offset:1024 sc1
    buffer_load_dwordx4 a[136:139], v11, s[48:51], s12 offen offset:2048 sc1
    buffer_load_dwordx4 a[140:143], v11, s[48:51], s12 offen offset:3072 sc1
    buffer_load_dwordx4 a[144:147], v11, s[48:51], s13 offen offset:0 sc1
    buffer_load_dwordx4 a[148:151], v11, s[48:51], s13 offen offset:1024 sc1
    buffer_load_dwordx4 a[152:155], v11, s[48:51], s13 offen offset:2048 sc1
    buffer_load_dwordx4 a[156:159], v11, s[48:51], s13 offen offset:3072 sc1
    buffer_load_dwordx4 a[160:163], v11, s[48:51], s14 offen offset:0 sc1
    buffer_load_dwordx4 a[164:167], v11, s[48:51], s14 offen offset:1024 sc1
    buffer_load_dwordx4 a[168:171], v11, s[48:51], s14 offen offset:2048 sc1
    buffer_load_dwordx4 a[172:175], v11, s[48:51], s14 offen offset:3072 sc1
    s_waitcnt lgkmcnt(0)
    s_barrier
    ds_read_b128 a[96:99], v7 offset:24576
    ds_read_b128 a[100:103], v8 offset:24576
    ds_read_b128 a[104:107], v9 offset:24576
    ds_read_b128 a[108:111], v10 offset:24576
    ds_read_b128 a[112:115], v7 offset:28672
    ds_read_b128 a[116:119], v8 offset:28672
    ds_read_b128 a[120:123], v9 offset:28672
    ds_read_b128 a[124:127], v10 offset:28672
    ds_read_b128 v[96:99], v20 offset:32768
    ds_read_b128 v[100:103], v20 offset:32784
    buffer_load_dwordx4 a[176:179], v11, s[48:51], s15 offen offset:0 sc1
    buffer_load_dwordx4 a[180:183], v11, s[48:51], s15 offen offset:1024 sc1
    buffer_load_dwordx4 a[184:187], v11, s[48:51], s15 offen offset:2048 sc1
    buffer_load_dwordx4 a[188:191], v11, s[48:51], s15 offen offset:3072 sc1
    s_branch L_xloop
L_fail7:
    s_waitcnt lgkmcnt(0)
    s_barrier
    ds_read_b128 a[96:99], v7 offset:24576
    ds_read_b128 a[100:103], v8 offset:24576
    ds_read_b128 a[104:107], v9 offset:24576
    ds_read_b128 a[108:111], v10 offset:24576
    ds_read_b128 a[112:115], v7 offset:28672
    ds_read_b128 a[116:119], v8 offset:28672
    ds_read_b128 a[120:123], v9 offset:28672
    ds_read_b128 a[124:127], v10 offset:28672
    ds_read_b128 v[96:99], v20 offset:32768
    ds_read_b128 v[100:103], v20 offset:32784
L_fA:
    s_cmp_ge_u32 s16, 7
    s_cbranch_scc1 L_vpA
    s_lshl_b32 s17, s16, 6
    s_and_b32 s17, s17, 0x40
    s_load_dwordx2 s[96:97], s[18:19], s17
    s_load_dwordx2 s[80:81], s[20:21], s79 offset:0
    s_load_dwordx2 s[82:83], s[20:21], s79 offset:128
    s_add_u32 s79, s79, 4096
    s_add_u32 s16, s16, 1
    s_waitcnt lgkmcnt(0)
    s_cmp_eq_u32 s96, 0
    s_cbranch_scc1 L_fA
    s_cmp_lg_u64 s[80:81], s[96:97]
    s_cbranch_scc1 L_fA
    s_cmp_lg_u64 s[82:83], s[96:97]
    s_cbranch_scc1 L_fA
    s_branch L_xokA
L_vpA:
    buffer_load_dwordx2 v[28:29], v18, s[44:47], 0 offen sc1
    buffer_load_dwordx2 v[32:33], v17, s[48:51], s79 offen sc1
    s_add_u32 s16, s16, 1
    s_waitcnt vmcnt(0)
    v_min_u32 v1, v28, v29
    v_cmp_ne_u64 s[22:23], v[28:29], v[32:33]
    v_cmp_eq_u32 vcc, 0, v1
    s_cmp_ge_u32 s16, 0x40000
    s_cbranch_scc1 L_xokA
    s_or_b64 s[22:23], vcc, s[22:23]
    s_cbranch_scc1 L_vpA
    s_branch L_xokA

L_xokA:
    buffer_load_dwordx4 a[128:131], v11, s[48:51], s12 offen offset:0 sc1
    buffer_load_dwordx4 a[132:135], v11, s[48:51], s12 offen offset:1024 sc1
    buffer_load_dwordx4 a[136:139], v11, s[48:51], s12 offen offset:2048 sc1
    buffer_load_dwordx4 a[140:143], v11, s[48:51], s12 offen offset:3072 sc1
    buffer_load_dwordx4 a[144:147], v11, s[48:51], s13 offen offset:0 sc1
    buffer_load_dwordx4 a[148:151], v11, s[48:51], s13 offen offset:1024 sc1
    buffer_load_dwordx4 a[152:155], v11, s[48:51], s13 offen offset:2048 sc1
    buffer_load_dwordx4 a[156:159], v11, s[48:51], s13 offen offset:3072 sc1
    buffer_load_dwordx4 a[160:163], v11, s[48:51], s14 offen offset:0 sc1
    buffer_load_dwordx4 a[164:167], v11, s[48:51], s14 offen offset:1024 sc1
    buffer_load_dwordx4 a[168:171], v11, s[48:51], s14 offen offset:2048 sc1
    buffer_load_dwordx4 a[172:175], v11, s[48:51], s14 offen offset:3072 sc1
    buffer_load_dwordx4 a[176:179], v11, s[48:51], s15 offen offset:0 sc1
    buffer_load_dwordx4 a[180:183], v11, s[48:51], s15 offen offset:1024 sc1
    buffer_load_dwordx4 a[184:187], v11, s[48:51], s15 offen offset:2048 sc1
    buffer_load_dwordx4 a[188:191], v11, s[48:51], s15 offen offset:3072 sc1
    s_branch L_xloop
L_fB:
    s_cmp_ge_u32 s16, 7
    s_cbranch_scc1 L_vpB
    s_lshl_b32 s17, s16, 6
    s_and_b32 s17, s17, 0x40
    s_load_dwordx2 s[96:97], s[18:19], s17
    s_load_dwordx2 s[80:81], s[20:21], s79 offset:0
    s_load_dwordx2 s[82:83], s[20:21], s79 offset:128
    s_add_u32 s79, s79, 4096
    s_add_u32 s16, s16, 1
    s_waitcnt lgkmcnt(0)
    s_cmp_eq_u32 s96, 0
    s_cbranch_scc1 L_fB
    s_cmp_lg_u64 s[80:81], s[96:97]
    s_cbranch_scc1 L_fB
    s_cmp_lg_u64 s[82:83], s[96:97]
    s_cbranch_scc1 L_fB
    s_branch L_xokB
L_vpB:
    buffer_load_dwordx2 v[28:29], v18, s[44:47], 0 offen sc1
    buffer_load_dwordx2 v[32:33], v17, s[48:51], s79 offen sc1
    s_add_u32 s16, s16, 1
    s_waitcnt vmcnt(0)
    v_min_u32 v1, v28, v29
    v_cmp_ne_u64 s[22:23], v[28:29], v[32:33]
    v_cmp_eq_u32 vcc, 0, v1
    s_cmp_ge_u32 s16, 0x40000
    s_cbranch_scc1 L_xokB
    s_or_b64 s[22:23], vcc, s[22:23]
    s_cbranch_scc1 L_vpB
    s_branch L_xokB

L_codeend:
    s_endpgm
.section .rodata,"a"
.p2align 6
.amdhsa_kernel standalone__w8a8_smoothquant_per_tensor_per_channel_int8_activations_weights__sampling_kernel
  .amdhsa_next_free_vgpr 512
  .amdhsa_next_free_sgpr 100
  .amdhsa_accum_offset 256
  .amdhsa_group_segment_fixed_size 0
  .amdhsa_kernarg_size 72
  .amdhsa_user_sgpr_count 2
  .amdhsa_user_sgpr_kernarg_segment_ptr 1
  .amdhsa_system_sgpr_workgroup_id_x 1
  .amdhsa_float_denorm_mode_32 3
.end_amdhsa_kernel
```
